```python
import torch

def _softmax(x, axis=-1):
    return torch.softmax(x, dim=axis)
def _gelu(x):
    return torch.nn.functional.gelu(x, approximate="tanh")
def _silu(x):
    return torch.nn.functional.silu(x)
def _sigmoid(x):
    return torch.sigmoid(x)
def _layernorm(x, axis=-1, eps=1e-5):
    m = x.mean(dim=axis, keepdim=True)
    v = x.var(dim=axis, keepdim=True, unbiased=False)
    return (x - m) / torch.sqrt(v + eps)
def _scatter_add(tgt, idx, src, axis=0):
    return tgt.clone().index_add_(axis, idx, src)
def _segment_sum(src, seg, n):
    out = torch.zeros((n,) + src.shape[1:], dtype=src.dtype)
    return out.index_add_(0, seg, src)
def _pad(x, pw):
    flat = tuple(v for pair in reversed(pw) for v in pair)
    return torch.nn.functional.pad(x, flat)

kernel_name = 'standalone__sequential_behavior_din__recsys'

def setup_inputs():

    _w = (lambda a: (lambda t: t.to(torch.bfloat16) if t.is_floating_point() else t)(torch.as_tensor(a)))
    B, L, D = 4096, 200, 32
    H = D
    return {
        "target": _w((lambda *s: torch.randn(*s, dtype=torch.bfloat16) * 1.6)(B, D)),
        "hist": _w((lambda *s: torch.randn(*s, dtype=torch.bfloat16) * 1.6)(B, L, D)),
        "mask": _w((lambda lo, hi, *s: torch.randint(lo, hi, s))(0, 2, B, L).to(float)),
        "w1": _w((lambda *s: torch.randn(*s, dtype=torch.bfloat16) * 1.6)(4 * D, H) * (4 * D) ** -0.5),
        "b1": _w((lambda *s: torch.randn(*s, dtype=torch.bfloat16) * 6.4)(H) * 0.1),
        "w2": _w((lambda *s: torch.randn(*s, dtype=torch.bfloat16) * 0.05)(H, 1) * H ** -0.5),
        "b2": _w((lambda *s: torch.randn(*s, dtype=torch.bfloat16) * 0.4)(1) * 0.1),
    }

def reference(target, hist, mask, w1, b1, w2, b2):
    L = hist.shape[1]
    tgt = (lambda x, n, axis: torch.repeat_interleave(x, n, dim=axis))(target[:, None, :], L, axis=1)
    feat = torch.concatenate([hist, tgt, hist - tgt, hist * tgt], axis=-1)
    h = _sigmoid(feat @ w1 + b1)
    scores = (h @ w2 + b2)[..., 0] * mask
    return torch.einsum('bl,bld->bd', scores, hist)
```

```asm
; @launch grid=(256,1,1) block=(1024,1,1) lds=96768
.amdgcn_target "amdgcn-amd-amdhsa--gfx950"
.text
.globl standalone__sequential_behavior_din__recsys_kernel
.p2align 8
.type standalone__sequential_behavior_din__recsys_kernel,@function
standalone__sequential_behavior_din__recsys_kernel:
  s_cmp_ge_u32 s2, 256
  s_cbranch_scc1 L_end
  s_load_dwordx16 s[4:19], s[0:1], 0
  v_lshrrev_b32 v1, 6, v0
  v_and_b32 v4, 63, v0
  v_readfirstlane_b32 s64, v1
  v_lshlrev_b32 v1, 1, v4
  v_mov_b32 v17, 0
  v_mov_b32 v19, 0
  v_mov_b32 v21, 0
  v_mov_b32 v23, 0
  s_lshl_b32 s3, s2, 4
  s_add_u32 s3, s3, s64
  s_mul_i32 s70, s3, 400
  s_mov_b32 s26, 400
  s_mov_b32 s27, 0x20000
  s_lshr_b32 s66, s64, 2
  s_cmp_eq_u32 s66, 0
  s_cbranch_scc0 L_pr0
  s_setprio 3
L_pr0:
  s_cmp_eq_u32 s66, 1
  s_cbranch_scc0 L_pr1
  s_setprio 2
L_pr1:
  s_cmp_eq_u32 s66, 2
  s_cbranch_scc0 L_pr2
  s_setprio 1
L_pr2:
  v_and_b32 v2, 15, v0
  v_bfe_u32 v3, v0, 4, 2
  s_mul_i32 s69, s3, 12800
  s_lshl_b32 s71, s3, 6
  s_mov_b32 s22, 12800
  s_mov_b32 s23, 0x20000
  s_mov_b32 s30, 64
  s_mov_b32 s31, 0x20000
  s_mov_b32 s38, 64
  s_mov_b32 s39, 0x20000
  s_mov_b32 s34, 8192
  s_mov_b32 s35, 0x20000
  s_mov_b32 s42, 64
  s_mov_b32 s43, 0x20000
  s_lshl_b32 s62, s64, 11
  s_add_u32 s62, s62, 23040
  s_mul_i32 s67, s64, 2560
  s_add_u32 s67, s67, 55808
  v_lshlrev_b32 v5, 4, v3
  v_lshlrev_b32 v10, 4, v4
  s_and_b32 s44, s64, 7
  s_lshl_b32 s44, s44, 10
  s_and_b32 s45, s64, 1
  s_lshl_b32 s45, s45, 10
  s_add_u32 s45, s45, 8192
  s_mov_b32 m0, s44
  s_waitcnt lgkmcnt(0)
  s_add_u32 s24, s8, s70
  s_addc_u32 s25, s9, 0
  buffer_load_short_d16_hi v17, v1, s[24:27], 0 offen offset:0
  buffer_load_short_d16_hi v19, v1, s[24:27], 0 offen offset:128
  buffer_load_short_d16_hi v21, v1, s[24:27], 0 offen offset:256
  buffer_load_short_d16_hi v23, v1, s[24:27], 0 offen offset:384
  s_add_u32 s28, s4, s71
  s_addc_u32 s29, s5, 0
  s_add_u32 s20, s6, s69
  s_addc_u32 s21, s7, 0
  s_add_u32 s36, s18, s71
  s_addc_u32 s37, s19, 0
  s_cmp_ge_u32 s64, 8
  s_cbranch_scc1 L_noX
  s_mov_b32 s32, s10
  s_mov_b32 s33, s11
  buffer_load_dwordx4 v10, s[32:35], s44 offen lds
  s_cmp_ge_u32 s64, 4
  s_cbranch_scc1 L_noX
  s_bitcmp1_b32 s64, 0
  s_cselect_b32 s40, s14, s12
  s_cselect_b32 s41, s15, s13
  s_mov_b32 m0, s45
  s_nop 0
  buffer_load_dwordx4 v10, s[40:43], 0 offen lds
L_noX:
  buffer_load_dwordx4 v[124:127], v5, s[28:31], 0 offen
  s_cmp_ge_u32 s64, 8
  s_cbranch_scc1 L_noD
  v_and_b32 v13, 15, v0
  v_lshl_add_u32 v13, v13, 6, v5
  buffer_load_dwordx4 v[32:35], v13, s[20:23], 0 offen offset:0 nt
L_noD:
  s_cmp_eq_u32 s66, 1
  s_cbranch_scc1 L_q1
  s_cmp_eq_u32 s66, 2
  s_cbranch_scc1 L_q2
  s_cmp_eq_u32 s66, 3
  s_cbranch_scc1 L_q3
L_q0:
  v_mov_b32 v30, 0x10000
  v_mov_b32 v31, 0
  v_add_u32 v12, s62, v10
  ds_write2_b64 v12, v[30:31], v[30:31] offset0:0 offset1:1
  ds_write2_b64 v12, v[30:31], v[30:31] offset0:128 offset1:129
  v_lshlrev_b32 v16, 6, v4
  v_or_b32 v18, 4096, v16
  v_or_b32 v20, 8192, v16
  v_or_b32 v22, 12288, v16
  v_lshl_add_u32 v6, v2, 3, s62
  s_waitcnt vmcnt(4)
  v_cmp_ne_u32 s[52:53], 0, v17
  v_cmp_ne_u32 s[54:55], 0, v19
  v_cmp_ne_u32 s[56:57], 0, v21
  v_cmp_ne_u32 s[58:59], 0, v23
  s_mov_b64 s[90:91], s[52:53]
  s_or_b32 s52, s52, 0xffff
  s_bcnt1_i32_b64 s46, s[52:53]
  v_mbcnt_lo_u32_b32 v12, s52, 0
  s_bcnt1_i32_b64 s47, s[54:55]
  v_mbcnt_lo_u32_b32 v13, s54, 0
  s_bcnt1_i32_b64 s48, s[56:57]
  v_mbcnt_lo_u32_b32 v14, s56, 0
  s_bcnt1_i32_b64 s49, s[58:59]
  v_mbcnt_lo_u32_b32 v15, s58, 0
  s_lshl3_add_u32 s73, s46, s62
  v_mbcnt_hi_u32_b32 v12, s53, v12
  v_mbcnt_hi_u32_b32 v13, s55, v13
  v_mbcnt_hi_u32_b32 v14, s57, v14
  v_mbcnt_hi_u32_b32 v15, s59, v15
  s_lshl3_add_u32 s74, s47, s73
  s_lshl3_add_u32 s75, s48, s74
  v_lshl_add_u32 v12, v12, 3, s62
  v_lshl_add_u32 v13, v13, 3, s73
  v_lshl_add_u32 v14, v14, 3, s74
  v_lshl_add_u32 v15, v15, 3, s75
  s_mov_b64 exec, s[52:53]
  ds_write_b64 v12, v[16:17]
  s_mov_b64 exec, s[54:55]
  ds_write_b64 v13, v[18:19]
  s_mov_b64 exec, s[56:57]
  ds_write_b64 v14, v[20:21]
  s_mov_b64 exec, s[58:59]
  ds_write_b64 v15, v[22:23]
  s_mov_b64 exec, -1
  ds_read_b32 v112, v6 offset:0
  ds_read_b32 v113, v6 offset:128
  ds_read_b32 v114, v6 offset:256
  ds_read_b32 v115, v6 offset:384
  ds_read_b32 v116, v6 offset:512
  ds_read_b32 v117, v6 offset:640
  ds_read_b32 v118, v6 offset:768
  ds_read_b32 v119, v6 offset:896
  s_waitcnt lgkmcnt(6)
  v_add_u32 v113, v113, v5
  buffer_load_dwordx4 v[36:39], v113, s[20:23], 0 offen nt
  s_waitcnt lgkmcnt(5)
  v_add_u32 v114, v114, v5
  buffer_load_dwordx4 v[40:43], v114, s[20:23], 0 offen nt
  s_waitcnt lgkmcnt(4)
  v_add_u32 v115, v115, v5
  buffer_load_dwordx4 v[44:47], v115, s[20:23], 0 offen nt
  s_waitcnt lgkmcnt(3)
  v_add_u32 v116, v116, v5
  buffer_load_dwordx4 v[48:51], v116, s[20:23], 0 offen nt
  s_waitcnt lgkmcnt(2)
  v_add_u32 v117, v117, v5
  buffer_load_dwordx4 v[52:55], v117, s[20:23], 0 offen nt
  s_waitcnt lgkmcnt(1)
  v_add_u32 v118, v118, v5
  buffer_load_dwordx4 v[56:59], v118, s[20:23], 0 offen nt
  s_waitcnt lgkmcnt(0)
  v_add_u32 v119, v119, v5
  buffer_load_dwordx4 v[60:63], v119, s[20:23], 0 offen nt
  s_add_u32 s60, s46, s47
  s_add_u32 s60, s60, s48
  s_add_u32 s60, s60, s49
  v_cmp_eq_u32 s[86:87], 1.0, v17
  s_nop 0
  s_xor_b64 s[84:85], s[86:87], s[90:91]
  v_cmp_eq_u32 s[88:89], 1.0, v19
  s_nop 0
  s_xor_b64 s[88:89], s[88:89], s[54:55]
  s_or_b64 s[84:85], s[84:85], s[88:89]
  v_cmp_eq_u32 s[86:87], 1.0, v21
  s_nop 0
  s_xor_b64 s[86:87], s[86:87], s[56:57]
  s_or_b64 s[84:85], s[84:85], s[86:87]
  v_cmp_eq_u32 s[88:89], 1.0, v23
  s_nop 0
  s_xor_b64 s[88:89], s[88:89], s[58:59]
  s_or_b64 s[84:85], s[84:85], s[88:89]
  s_add_u32 s61, s60, 15
  s_lshr_b32 s61, s61, 4
  v_lshl_add_u32 v7, v3, 5, s62
  v_mul_u32_u24 v8, 80, v2
  v_add3_u32 v8, v8, v5, s67
  v_lshrrev_b32 v13, 2, v2
  v_lshl_add_u32 v14, v3, 2, v13
  v_mul_u32_u24 v14, 80, v14
  v_and_b32 v15, 3, v2
  v_lshlrev_b32 v15, 3, v15
  v_add3_u32 v9, v14, v15, s67
  s_mov_b32 s63, 0xffff0000
  s_mov_b32 s50, 0xbfb8aa3b
  s_mov_b32 s51, 0xbfb8aa3b
  s_mov_b32 s68, 0
  s_waitcnt vmcnt(8)
  s_waitcnt lgkmcnt(0)
  s_barrier
  s_barrier
  s_branch L_setup
L_q1:
  v_mov_b32 v30, 0x10000
  v_mov_b32 v31, 0
  v_add_u32 v12, s62, v10
  ds_write2_b64 v12, v[30:31], v[30:31] offset0:0 offset1:1
  ds_write2_b64 v12, v[30:31], v[30:31] offset0:128 offset1:129
  v_lshlrev_b32 v16, 6, v4
  v_or_b32 v18, 4096, v16
  v_or_b32 v20, 8192, v16
  v_or_b32 v22, 12288, v16
  s_mov_b32 s63, 0xffff0000
  s_mov_b32 s50, 0xbfb8aa3b
  s_mov_b32 s51, 0xbfb8aa3b
  s_mov_b32 s68, 0
  v_lshl_add_u32 v6, v2, 3, s62
  v_lshl_add_u32 v7, v3, 5, s62
  v_mul_u32_u24 v8, 80, v2
  v_add3_u32 v8, v8, v5, s67
  v_lshrrev_b32 v13, 2, v2
  v_lshl_add_u32 v14, v3, 2, v13
  v_mul_u32_u24 v14, 80, v14
  v_and_b32 v15, 3, v2
  v_lshlrev_b32 v15, 3, v15
  v_add3_u32 v9, v14, v15, s67
  s_waitcnt vmcnt(3)
  v_cmp_ne_u32 s[52:53], 0, v17
  v_cmp_ne_u32 s[54:55], 0, v19
  v_cmp_ne_u32 s[56:57], 0, v21
  v_cmp_ne_u32 s[58:59], 0, v23
  s_mov_b64 s[90:91], s[52:53]
  s_or_b32 s52, s52, 0xffff
  s_bcnt1_i32_b64 s46, s[52:53]
  v_mbcnt_lo_u32_b32 v12, s52, 0
  s_bcnt1_i32_b64 s47, s[54:55]
  v_mbcnt_lo_u32_b32 v13, s54, 0
  s_bcnt1_i32_b64 s48, s[56:57]
  v_mbcnt_lo_u32_b32 v14, s56, 0
  s_bcnt1_i32_b64 s49, s[58:59]
  v_mbcnt_lo_u32_b32 v15, s58, 0
  s_lshl3_add_u32 s73, s46, s62
  v_mbcnt_hi_u32_b32 v12, s53, v12
  v_mbcnt_hi_u32_b32 v13, s55, v13
  v_mbcnt_hi_u32_b32 v14, s57, v14
  v_mbcnt_hi_u32_b32 v15, s59, v15
  s_lshl3_add_u32 s74, s47, s73
  s_lshl3_add_u32 s75, s48, s74
  s_add_u32 s60, s46, s47
  v_lshl_add_u32 v12, v12, 3, s62
  v_lshl_add_u32 v13, v13, 3, s73
  v_lshl_add_u32 v14, v14, 3, s74
  v_lshl_add_u32 v15, v15, 3, s75
  s_add_u32 s60, s60, s48
  s_add_u32 s60, s60, s49
  s_mov_b64 exec, s[52:53]
  ds_write_b64 v12, v[16:17]
  s_mov_b64 exec, s[54:55]
  ds_write_b64 v13, v[18:19]
  s_mov_b64 exec, s[56:57]
  ds_write_b64 v14, v[20:21]
  s_mov_b64 exec, s[58:59]
  ds_write_b64 v15, v[22:23]
  s_mov_b64 exec, -1
  v_cmp_eq_u32 s[86:87], 1.0, v17
  s_nop 0
  s_xor_b64 s[84:85], s[86:87], s[90:91]
  v_cmp_eq_u32 s[88:89], 1.0, v19
  s_nop 0
  s_xor_b64 s[88:89], s[88:89], s[54:55]
  s_or_b64 s[84:85], s[84:85], s[88:89]
  v_cmp_eq_u32 s[86:87], 1.0, v21
  s_nop 0
  s_xor_b64 s[86:87], s[86:87], s[56:57]
  s_or_b64 s[84:85], s[84:85], s[86:87]
  v_cmp_eq_u32 s[88:89], 1.0, v23
  s_nop 0
  s_xor_b64 s[88:89], s[88:89], s[58:59]
  s_or_b64 s[84:85], s[84:85], s[88:89]
  ds_read_b32 v16, v6 offset:0
  ds_read_b32 v17, v6 offset:128
  ds_read_b32 v18, v6 offset:256
  ds_read_b32 v19, v6 offset:384
  ds_read_b32 v20, v6 offset:512
  ds_read_b32 v21, v6 offset:640
  ds_read_b32 v22, v6 offset:768
  ds_read_b32 v23, v6 offset:896
  s_add_u32 s61, s60, 15
  s_lshr_b32 s61, s61, 4
  s_waitcnt vmcnt(2)
  s_waitcnt lgkmcnt(0)
  s_barrier
  s_and_b32 s46, s64, 1
  s_bfe_u32 s47, s64, 0x10001
  s_lshl_b32 s48, s46, 5
  s_lshl_b32 s49, s47, 8
  s_add_u32 s48, s48, s49
  v_lshrrev_b32 v12, 2, v2
  v_lshl_add_u32 v12, v3, 3, v12
  v_lshlrev_b32 v12, 6, v12
  v_and_b32 v13, 3, v2
  v_lshlrev_b32 v13, 3, v13
  v_add3_u32 v12, v12, v13, s48
  ds_read_b64_tr_b16 v[96:97], v12 offset:0
  ds_read_b64_tr_b16 v[98:99], v12 offset:4096
  s_lshl1_add_u32 s46, s46, s47
  s_lshl_b32 s46, s46, 10
  v_add_u32 v13, s46, v10
  s_waitcnt lgkmcnt(0)
  v_lshlrev_b32 v100, 16, v96
  v_and_b32 v101, s63, v96
  v_lshlrev_b32 v102, 16, v97
  v_and_b32 v103, s63, v97
  v_lshlrev_b32 v104, 16, v98
  v_and_b32 v105, s63, v98
  v_lshlrev_b32 v106, 16, v99
  v_and_b32 v107, s63, v99
  v_pk_mul_f32 v[100:101], v[100:101], s[50:51]
  v_pk_mul_f32 v[102:103], v[102:103], s[50:51]
  v_pk_fma_f32 v[100:101], v[104:105], s[50:51], v[100:101]
  v_pk_fma_f32 v[102:103], v[106:107], s[50:51], v[102:103]
  ds_write_b128 v13, v[100:103] offset:10240
  s_waitcnt lgkmcnt(0)
  s_barrier
  s_waitcnt vmcnt(1) lgkmcnt(0)
  v_add_u32 v17, v17, v5
  buffer_load_dwordx4 v[36:39], v17, s[20:23], 0 offen nt
  v_add_u32 v18, v18, v5
  buffer_load_dwordx4 v[40:43], v18, s[20:23], 0 offen nt
  v_add_u32 v19, v19, v5
  buffer_load_dwordx4 v[44:47], v19, s[20:23], 0 offen nt
  v_add_u32 v20, v20, v5
  buffer_load_dwordx4 v[48:51], v20, s[20:23], 0 offen nt
  v_add_u32 v21, v21, v5
  buffer_load_dwordx4 v[52:55], v21, s[20:23], 0 offen nt
  v_add_u32 v22, v22, v5
  buffer_load_dwordx4 v[56:59], v22, s[20:23], 0 offen nt
  v_add_u32 v23, v23, v5
  buffer_load_dwordx4 v[60:63], v23, s[20:23], 0 offen nt
  s_branch L_setup
L_q2:
  v_mov_b32 v30, 0x10000
  v_mov_b32 v31, 0
  v_add_u32 v12, s62, v10
  ds_write2_b64 v12, v[30:31], v[30:31] offset0:0 offset1:1
  ds_write2_b64 v12, v[30:31], v[30:31] offset0:128 offset1:129
  v_lshlrev_b32 v16, 6, v4
  v_or_b32 v18, 4096, v16
  v_or_b32 v20, 8192, v16
  v_or_b32 v22, 12288, v16
  s_mov_b32 s63, 0xffff0000
  s_mov_b32 s50, 0xbfb8aa3b
  s_mov_b32 s51, 0xbfb8aa3b
  s_mov_b32 s68, 0
  v_lshl_add_u32 v6, v2, 3, s62
  v_lshl_add_u32 v7, v3, 5, s62
  v_mul_u32_u24 v8, 80, v2
  v_add3_u32 v8, v8, v5, s67
  v_lshrrev_b32 v13, 2, v2
  v_lshl_add_u32 v14, v3, 2, v13
  v_mul_u32_u24 v14, 80, v14
  v_and_b32 v15, 3, v2
  v_lshlrev_b32 v15, 3, v15
  v_add3_u32 v9, v14, v15, s67
  s_waitcnt lgkmcnt(0)
  s_barrier
  s_and_b32 s46, s64, 1
  s_bfe_u32 s47, s64, 0x10001
  s_lshl_b32 s48, s46, 5
  s_lshl_b32 s49, s47, 8
  s_add_u32 s48, s48, s49
  v_lshrrev_b32 v12, 2, v2
  v_lshl_add_u32 v12, v3, 3, v12
  v_lshlrev_b32 v12, 6, v12
  v_and_b32 v13, 3, v2
  v_lshlrev_b32 v13, 3, v13
  v_add3_u32 v12, v12, v13, s48
  ds_read_b64_tr_b16 v[96:97], v12 offset:2048
  ds_read_b64_tr_b16 v[98:99], v12 offset:4096
  s_lshl_b32 s46, s46, 11
  s_lshl3_add_u32 s46, s47, s46
  v_add_u32 v13, s46, v10
  s_waitcnt lgkmcnt(0)
  v_lshlrev_b32 v100, 16, v96
  v_and_b32 v101, s63, v96
  v_lshlrev_b32 v102, 16, v97
  v_and_b32 v103, s63, v97
  v_lshlrev_b32 v104, 16, v98
  v_and_b32 v105, s63, v98
  v_lshlrev_b32 v106, 16, v99
  v_and_b32 v107, s63, v99
  v_pk_mul_f32 v[100:101], v[100:101], s[50:51]
  v_pk_mul_f32 v[102:103], v[102:103], s[50:51]
  v_pk_fma_f32 v[100:101], v[104:105], s[50:51], v[100:101] neg_lo:[1,0,0] neg_hi:[1,0,0]
  v_pk_fma_f32 v[102:103], v[106:107], s[50:51], v[102:103] neg_lo:[1,0,0] neg_hi:[1,0,0]
  v_cvt_pk_bf16_f32 v96, v100, v101
  v_cvt_pk_bf16_f32 v97, v102, v103
  v_lshlrev_b32 v104, 16, v96
  v_and_b32 v105, s63, v96
  v_lshlrev_b32 v106, 16, v97
  v_and_b32 v107, s63, v97
  v_pk_add_f32 v[100:101], v[100:101], v[104:105] neg_lo:[0,1] neg_hi:[0,1]
  v_pk_add_f32 v[102:103], v[102:103], v[106:107] neg_lo:[0,1] neg_hi:[0,1]
  v_cvt_pk_bf16_f32 v98, v100, v101
  v_cvt_pk_bf16_f32 v99, v102, v103
  ds_write_b64 v13, v[96:97] offset:18432
  ds_write_b64 v13, v[98:99] offset:19456
  s_waitcnt lgkmcnt(0)
  s_barrier
  s_waitcnt vmcnt(0)
  v_cmp_ne_u32 s[52:53], 0, v17
  v_cmp_ne_u32 s[54:55], 0, v19
  v_cmp_ne_u32 s[56:57], 0, v21
  v_cmp_ne_u32 s[58:59], 0, v23
  s_bcnt1_i32_b64 s46, s[52:53]
  v_mbcnt_lo_u32_b32 v12, s52, 0
  s_bcnt1_i32_b64 s47, s[54:55]
  v_mbcnt_lo_u32_b32 v13, s54, 0
  s_bcnt1_i32_b64 s48, s[56:57]
  v_mbcnt_lo_u32_b32 v14, s56, 0
  s_bcnt1_i32_b64 s49, s[58:59]
  v_mbcnt_lo_u32_b32 v15, s58, 0
  s_lshl3_add_u32 s73, s46, s62
  v_mbcnt_hi_u32_b32 v12, s53, v12
  v_mbcnt_hi_u32_b32 v13, s55, v13
  v_mbcnt_hi_u32_b32 v14, s57, v14
  v_mbcnt_hi_u32_b32 v15, s59, v15
  s_lshl3_add_u32 s74, s47, s73
  s_lshl3_add_u32 s75, s48, s74
  s_add_u32 s60, s46, s47
  v_lshl_add_u32 v12, v12, 3, s62
  v_lshl_add_u32 v13, v13, 3, s73
  v_lshl_add_u32 v14, v14, 3, s74
  v_lshl_add_u32 v15, v15, 3, s75
  s_add_u32 s60, s60, s48
  s_add_u32 s60, s60, s49
  s_mov_b64 exec, s[52:53]
  ds_write_b64 v12, v[16:17]
  s_mov_b64 exec, s[54:55]
  ds_write_b64 v13, v[18:19]
  s_mov_b64 exec, s[56:57]
  ds_write_b64 v14, v[20:21]
  s_mov_b64 exec, s[58:59]
  ds_write_b64 v15, v[22:23]
  s_mov_b64 exec, -1
  v_cmp_eq_u32 s[86:87], 1.0, v17
  s_nop 0
  s_xor_b64 s[84:85], s[86:87], s[52:53]
  v_cmp_eq_u32 s[88:89], 1.0, v19
  s_nop 0
  s_xor_b64 s[88:89], s[88:89], s[54:55]
  s_or_b64 s[84:85], s[84:85], s[88:89]
  v_cmp_eq_u32 s[86:87], 1.0, v21
  s_nop 0
  s_xor_b64 s[86:87], s[86:87], s[56:57]
  s_or_b64 s[84:85], s[84:85], s[86:87]
  v_cmp_eq_u32 s[88:89], 1.0, v23
  s_nop 0
  s_xor_b64 s[88:89], s[88:89], s[58:59]
  s_or_b64 s[84:85], s[84:85], s[88:89]
  ds_read_b32 v16, v6 offset:0
  ds_read_b32 v17, v6 offset:128
  ds_read_b32 v18, v6 offset:256
  ds_read_b32 v19, v6 offset:384
  ds_read_b32 v20, v6 offset:512
  ds_read_b32 v21, v6 offset:640
  ds_read_b32 v22, v6 offset:768
  ds_read_b32 v23, v6 offset:896
  s_add_u32 s61, s60, 15
  s_lshr_b32 s61, s61, 4
  s_waitcnt vmcnt(0) lgkmcnt(0)
  s_branch L_setup
L_q3:
  s_load_dword s65, s[16:17], 0
  v_mov_b32 v30, 0x10000
  v_mov_b32 v31, 0
  v_add_u32 v12, s62, v10
  ds_write2_b64 v12, v[30:31], v[30:31] offset0:0 offset1:1
  ds_write2_b64 v12, v[30:31], v[30:31] offset0:128 offset1:129
  v_lshlrev_b32 v16, 6, v4
  v_or_b32 v18, 4096, v16
  v_or_b32 v20, 8192, v16
  v_or_b32 v22, 12288, v16
  s_mov_b32 s63, 0xffff0000
  s_mov_b32 s50, 0xbfb8aa3b
  s_mov_b32 s51, 0xbfb8aa3b
  s_mov_b32 s68, 0
  v_lshl_add_u32 v6, v2, 3, s62
  v_lshl_add_u32 v7, v3, 5, s62
  v_mul_u32_u24 v8, 80, v2
  v_add3_u32 v8, v8, v5, s67
  v_lshrrev_b32 v13, 2, v2
  v_lshl_add_u32 v14, v3, 2, v13
  v_mul_u32_u24 v14, 80, v14
  v_and_b32 v15, 3, v2
  v_lshlrev_b32 v15, 3, v15
  v_add3_u32 v9, v14, v15, s67
  s_waitcnt lgkmcnt(0)
  s_barrier
  s_and_b32 s46, s64, 1
  s_bfe_u32 s47, s64, 0x10001
  s_lshl_b32 s48, s46, 5
  s_lshl_b32 s49, s47, 8
  s_add_u32 s48, s48, s49
  v_lshrrev_b32 v12, 2, v2
  v_lshl_add_u32 v12, v3, 3, v12
  v_lshlrev_b32 v12, 6, v12
  v_and_b32 v13, 3, v2
  v_lshlrev_b32 v13, 3, v13
  v_add3_u32 v12, v12, v13, s48
  ds_read_b64_tr_b16 v[96:97], v12 offset:6144
  s_lshl1_add_u32 s46, s46, s47
  s_lshl_b32 s46, s46, 10
  v_add_u32 v13, s46, v10
  v_lshlrev_b32 v14, 1, v4
  ds_read_u16 v98, v14 offset:8192
  v_lshlrev_b32 v14, 2, v4
  s_waitcnt lgkmcnt(0)
  v_lshlrev_b32 v100, 16, v96
  v_and_b32 v101, s63, v96
  v_lshlrev_b32 v102, 16, v97
  v_and_b32 v103, s63, v97
  v_lshlrev_b32 v98, 16, v98
  s_lshl_b32 s65, s65, 16
  v_pk_mul_f32 v[100:101], v[100:101], s[50:51]
  v_pk_mul_f32 v[102:103], v[102:103], s[50:51]
  v_mul_f32 v98, s50, v98
  v_mov_b32 v99, s65
  ds_write_b128 v13, v[100:103] offset:14336
  ds_write_b32 v14, v98 offset:22528
  ds_write_b32 v14, v99 offset:22784
  s_waitcnt lgkmcnt(0)
  s_barrier
  s_waitcnt vmcnt(0)
  v_cmp_ne_u32 s[52:53], 0, v17
  v_cmp_ne_u32 s[54:55], 0, v19
  v_cmp_ne_u32 s[56:57], 0, v21
  v_cmp_ne_u32 s[58:59], 0, v23
  s_bcnt1_i32_b64 s46, s[52:53]
  v_mbcnt_lo_u32_b32 v12, s52, 0
  s_bcnt1_i32_b64 s47, s[54:55]
  v_mbcnt_lo_u32_b32 v13, s54, 0
  s_bcnt1_i32_b64 s48, s[56:57]
  v_mbcnt_lo_u32_b32 v14, s56, 0
  s_bcnt1_i32_b64 s49, s[58:59]
  v_mbcnt_lo_u32_b32 v15, s58, 0
  s_lshl3_add_u32 s73, s46, s62
  v_mbcnt_hi_u32_b32 v12, s53, v12
  v_mbcnt_hi_u32_b32 v13, s55, v13
  v_mbcnt_hi_u32_b32 v14, s57, v14
  v_mbcnt_hi_u32_b32 v15, s59, v15
  s_lshl3_add_u32 s74, s47, s73
  s_lshl3_add_u32 s75, s48, s74
  s_add_u32 s60, s46, s47
  v_lshl_add_u32 v12, v12, 3, s62
  v_lshl_add_u32 v13, v13, 3, s73
  v_lshl_add_u32 v14, v14, 3, s74
  v_lshl_add_u32 v15, v15, 3, s75
  s_add_u32 s60, s60, s48
  s_add_u32 s60, s60, s49
  s_mov_b64 exec, s[52:53]
  ds_write_b64 v12, v[16:17]
  s_mov_b64 exec, s[54:55]
  ds_write_b64 v13, v[18:19]
  s_mov_b64 exec, s[56:57]
  ds_write_b64 v14, v[20:21]
  s_mov_b64 exec, s[58:59]
  ds_write_b64 v15, v[22:23]
  s_mov_b64 exec, -1
  v_cmp_eq_u32 s[86:87], 1.0, v17
  s_nop 0
  s_xor_b64 s[84:85], s[86:87], s[52:53]
  v_cmp_eq_u32 s[88:89], 1.0, v19
  s_nop 0
  s_xor_b64 s[88:89], s[88:89], s[54:55]
  s_or_b64 s[84:85], s[84:85], s[88:89]
  v_cmp_eq_u32 s[86:87], 1.0, v21
  s_nop 0
  s_xor_b64 s[86:87], s[86:87], s[56:57]
  s_or_b64 s[84:85], s[84:85], s[86:87]
  v_cmp_eq_u32 s[88:89], 1.0, v23
  s_nop 0
  s_xor_b64 s[88:89], s[88:89], s[58:59]
  s_or_b64 s[84:85], s[84:85], s[88:89]
  ds_read_b32 v16, v6 offset:0
  ds_read_b32 v17, v6 offset:128
  ds_read_b32 v18, v6 offset:256
  ds_read_b32 v19, v6 offset:384
  ds_read_b32 v20, v6 offset:512
  ds_read_b32 v21, v6 offset:640
  ds_read_b32 v22, v6 offset:768
  ds_read_b32 v23, v6 offset:896
  s_add_u32 s61, s60, 15
  s_lshr_b32 s61, s61, 4
  s_waitcnt vmcnt(0) lgkmcnt(0)
L_setup:
  ds_read_b128 v[72:75], v5 offset:22528
  ds_read_b128 v[76:79], v5 offset:22592
  ds_read_b128 v[88:91], v10 offset:18432
  ds_read_b128 v[92:95], v10 offset:19456
  ds_read_b128 v[120:123], v10 offset:20480
  ds_read_b128 v[24:27], v10 offset:21504
  ds_read_b128 v[104:107], v10 offset:10240
  ds_read_b128 v[108:111], v10 offset:11264
  ds_read_b128 v[112:115], v10 offset:12288
  ds_read_b128 v[116:119], v10 offset:13312
  v_lshlrev_b32 v96, 16, v124
  v_and_b32 v97, s63, v124
  v_lshlrev_b32 v98, 16, v125
  v_and_b32 v99, s63, v125
  v_lshlrev_b32 v100, 16, v126
  v_and_b32 v101, s63, v126
  v_lshlrev_b32 v102, 16, v127
  v_and_b32 v103, s63, v127
  v_lshlrev_b32 v12, 3, v3
  s_waitcnt lgkmcnt(4)
  v_mfma_f32_16x16x32_bf16 v[72:75], v[88:91], v[124:127], v[72:75]
  v_mfma_f32_16x16x32_bf16 v[76:79], v[120:123], v[124:127], v[76:79]
  v_mfma_f32_16x16x32_bf16 v[72:75], v[92:95], v[124:127], v[72:75]
  v_mfma_f32_16x16x32_bf16 v[76:79], v[24:27], v[124:127], v[76:79]
  ds_read_b128 v[88:91], v10 offset:14336
  ds_read_b128 v[92:95], v10 offset:15360
  ds_read_b128 v[120:123], v10 offset:16384
  ds_read_b128 v[24:27], v10 offset:17408
  ds_read_b64 v[80:81], v12 offset:9216
  ds_read_b64 v[82:83], v12 offset:9248
  ds_read_b128 v[84:87], v5 offset:22784
  s_waitcnt lgkmcnt(6)
  v_pk_fma_f32 v[104:105], v[88:89], v[96:97], v[104:105]
  v_pk_fma_f32 v[106:107], v[90:91], v[98:99], v[106:107]
  v_cvt_pk_bf16_f32 v64, v104, v105
  v_cvt_pk_bf16_f32 v65, v106, v107
  s_waitcnt lgkmcnt(5)
  v_pk_fma_f32 v[108:109], v[92:93], v[100:101], v[108:109]
  v_pk_fma_f32 v[110:111], v[94:95], v[102:103], v[110:111]
  v_cvt_pk_bf16_f32 v66, v108, v109
  v_cvt_pk_bf16_f32 v67, v110, v111
  s_waitcnt lgkmcnt(4)
  v_pk_fma_f32 v[112:113], v[120:121], v[96:97], v[112:113]
  v_pk_fma_f32 v[114:115], v[122:123], v[98:99], v[114:115]
  v_cvt_pk_bf16_f32 v68, v112, v113
  v_cvt_pk_bf16_f32 v69, v114, v115
  s_waitcnt lgkmcnt(3)
  v_pk_fma_f32 v[116:117], v[24:25], v[100:101], v[116:117]
  v_pk_fma_f32 v[118:119], v[26:27], v[102:103], v[118:119]
  v_cvt_pk_bf16_f32 v70, v116, v117
  v_cvt_pk_bf16_f32 v71, v118, v119
  s_waitcnt lgkmcnt(0)
  s_cmp_eq_u32 s66, 0
  s_cbranch_scc0 L_g0
  s_cmp_eq_u32 s61, 0
  s_cbranch_scc1 L_zero
  s_cmp_eq_u64 s[84:85], 0
  s_cbranch_scc1 L_roundU8
  s_branch L_round8
L_g0:
  s_cmp_eq_u32 s66, 1
  s_cbranch_scc0 L_g1
  s_cmp_eq_u32 s61, 0
  s_cbranch_scc1 L_zero
  s_cmp_eq_u64 s[84:85], 0
  s_cbranch_scc1 L_roundU8
  s_branch L_round8
L_g1:
  s_cmp_eq_u32 s66, 2
  s_cbranch_scc0 L_g2
  v_add_u32 v16, v16, v5
  buffer_load_dwordx4 v[32:35], v16, s[20:23], 0 offen nt
  v_add_u32 v17, v17, v5
  buffer_load_dwordx4 v[36:39], v17, s[20:23], 0 offen nt
  v_add_u32 v18, v18, v5
  buffer_load_dwordx4 v[40:43], v18, s[20:23], 0 offen nt
  v_add_u32 v19, v19, v5
  buffer_load_dwordx4 v[44:47], v19, s[20:23], 0 offen nt
  v_add_u32 v20, v20, v5
  buffer_load_dwordx4 v[48:51], v20, s[20:23], 0 offen nt
  v_add_u32 v21, v21, v5
  buffer_load_dwordx4 v[52:55], v21, s[20:23], 0 offen nt
  v_add_u32 v22, v22, v5
  buffer_load_dwordx4 v[56:59], v22, s[20:23], 0 offen nt
  v_add_u32 v23, v23, v5
  buffer_load_dwordx4 v[60:63], v23, s[20:23], 0 offen nt
  s_cmp_eq_u32 s61, 0
  s_cbranch_scc1 L_zero
  s_cmp_eq_u64 s[84:85], 0
  s_cbranch_scc1 L_roundU8
  s_branch L_round8
L_g2:
  v_add_u32 v16, v16, v5
  buffer_load_dwordx4 v[32:35], v16, s[20:23], 0 offen nt
  v_add_u32 v17, v17, v5
  buffer_load_dwordx4 v[36:39], v17, s[20:23], 0 offen nt
  v_add_u32 v18, v18, v5
  buffer_load_dwordx4 v[40:43], v18, s[20:23], 0 offen nt
  v_add_u32 v19, v19, v5
  buffer_load_dwordx4 v[44:47], v19, s[20:23], 0 offen nt
  v_add_u32 v20, v20, v5
  buffer_load_dwordx4 v[48:51], v20, s[20:23], 0 offen nt
  v_add_u32 v21, v21, v5
  buffer_load_dwordx4 v[52:55], v21, s[20:23], 0 offen nt
  v_add_u32 v22, v22, v5
  buffer_load_dwordx4 v[56:59], v22, s[20:23], 0 offen nt
  v_add_u32 v23, v23, v5
  buffer_load_dwordx4 v[60:63], v23, s[20:23], 0 offen nt
  s_cmp_eq_u32 s61, 0
  s_cbranch_scc1 L_zero
  s_cmp_eq_u64 s[84:85], 0
  s_cbranch_scc1 L_roundU8
  s_branch L_round8
L_roundU8:
  s_waitcnt vmcnt(7)
  v_mfma_f32_16x16x32_bf16 v[96:99], v[64:67], v[32:35], v[72:75]
  ds_write_b128 v8, v[32:35] offset:0
  v_mfma_f32_16x16x32_bf16 v[100:103], v[68:71], v[32:35], v[76:79]
  s_nop 5
  v_exp_f32 v96, v96
  ds_read2_b32 v[24:25], v7 offset0:1 offset1:3
  v_exp_f32 v97, v97
  ds_read2_b32 v[26:27], v7 offset0:5 offset1:7
  v_exp_f32 v98, v98
  v_exp_f32 v99, v99
  v_exp_f32 v100, v100
  v_exp_f32 v101, v101
  v_exp_f32 v102, v102
  v_exp_f32 v103, v103
  v_pk_add_f32 v[96:97], v[96:97], 1.0 op_sel_hi:[1,0]
  v_pk_add_f32 v[98:99], v[98:99], 1.0 op_sel_hi:[1,0]
  v_pk_add_f32 v[100:101], v[100:101], 1.0 op_sel_hi:[1,0]
  v_pk_add_f32 v[102:103], v[102:103], 1.0 op_sel_hi:[1,0]
  v_rcp_f32 v96, v96
  v_rcp_f32 v97, v97
  v_rcp_f32 v98, v98
  v_cvt_pk_bf16_f32 v112, v96, v97
  v_rcp_f32 v99, v99
  v_rcp_f32 v100, v100
  v_cvt_pk_bf16_f32 v113, v98, v99
  v_rcp_f32 v101, v101
  v_rcp_f32 v102, v102
  v_rcp_f32 v103, v103
  v_cvt_pk_bf16_f32 v114, v100, v101
  v_cvt_pk_bf16_f32 v115, v102, v103
  s_cmp_eq_u32 s61, 1
  ds_read_b64_tr_b16 v[120:121], v9 offset:0
  v_mfma_f32_16x16x32_bf16 v[116:119], v[112:115], v[80:83], v[84:87]
  ds_read_b64_tr_b16 v[122:123], v9 offset:32
  s_cbranch_scc1 L_flushDU0
  s_waitcnt vmcnt(6)
  v_mfma_f32_16x16x32_bf16 v[104:107], v[64:67], v[36:39], v[72:75]
  ds_write_b128 v8, v[36:39] offset:1280
  v_mfma_f32_16x16x32_bf16 v[108:111], v[68:71], v[36:39], v[76:79]
  s_waitcnt lgkmcnt(1)
  s_nop 0
  v_pk_mul_f32 v[116:117], v[116:117], v[24:25]
  v_pk_mul_f32 v[118:119], v[118:119], v[26:27]
  v_cvt_pk_bf16_f32 v28, v116, v117
  v_cvt_pk_bf16_f32 v29, v118, v119
  s_nop 1
  v_mfma_f32_16x16x16_bf16 v[88:91], v[28:29], v[120:121], 0
  v_exp_f32 v104, v104
  v_exp_f32 v105, v105
  v_mfma_f32_16x16x16_bf16 v[92:95], v[28:29], v[122:123], 0
  v_exp_f32 v106, v106
  v_exp_f32 v107, v107
  v_exp_f32 v108, v108
  v_exp_f32 v109, v109
  v_exp_f32 v110, v110
  v_exp_f32 v111, v111
  v_pk_add_f32 v[104:105], v[104:105], 1.0 op_sel_hi:[1,0]
  v_pk_add_f32 v[106:107], v[106:107], 1.0 op_sel_hi:[1,0]
  v_pk_add_f32 v[108:109], v[108:109], 1.0 op_sel_hi:[1,0]
  v_pk_add_f32 v[110:111], v[110:111], 1.0 op_sel_hi:[1,0]
  v_rcp_f32 v104, v104
  v_rcp_f32 v105, v105
  v_rcp_f32 v106, v106
  v_cvt_pk_bf16_f32 v112, v104, v105
  v_rcp_f32 v107, v107
  v_rcp_f32 v108, v108
  v_cvt_pk_bf16_f32 v113, v106, v107
  v_rcp_f32 v109, v109
  v_rcp_f32 v110, v110
  v_rcp_f32 v111, v111
  v_cvt_pk_bf16_f32 v114, v108, v109
  v_cvt_pk_bf16_f32 v115, v110, v111
  s_cmp_eq_u32 s61, 2
  ds_read_b64_tr_b16 v[120:121], v9 offset:1280
  v_mfma_f32_16x16x32_bf16 v[116:119], v[112:115], v[80:83], v[84:87]
  ds_read_b64_tr_b16 v[122:123], v9 offset:1312
  s_cbranch_scc1 L_flushDUn
  s_waitcnt vmcnt(5)
  v_mfma_f32_16x16x32_bf16 v[96:99], v[64:67], v[40:43], v[72:75]
  ds_write_b128 v8, v[40:43] offset:0
  v_mfma_f32_16x16x32_bf16 v[100:103], v[68:71], v[40:43], v[76:79]
  s_waitcnt lgkmcnt(1)
  s_nop 0
  v_cvt_pk_bf16_f32 v28, v116, v117
  v_cvt_pk_bf16_f32 v29, v118, v119
  s_nop 1
  v_mfma_f32_16x16x16_bf16 v[88:91], v[28:29], v[120:121], v[88:91]
  v_exp_f32 v96, v96
  v_exp_f32 v97, v97
  v_mfma_f32_16x16x16_bf16 v[92:95], v[28:29], v[122:123], v[92:95]
  v_exp_f32 v98, v98
  v_exp_f32 v99, v99
  v_exp_f32 v100, v100
  v_exp_f32 v101, v101
  v_exp_f32 v102, v102
  v_exp_f32 v103, v103
  v_pk_add_f32 v[96:97], v[96:97], 1.0 op_sel_hi:[1,0]
  v_pk_add_f32 v[98:99], v[98:99], 1.0 op_sel_hi:[1,0]
  v_pk_add_f32 v[100:101], v[100:101], 1.0 op_sel_hi:[1,0]
  v_pk_add_f32 v[102:103], v[102:103], 1.0 op_sel_hi:[1,0]
  v_rcp_f32 v96, v96
  v_rcp_f32 v97, v97
  v_rcp_f32 v98, v98
  v_cvt_pk_bf16_f32 v112, v96, v97
  v_rcp_f32 v99, v99
  v_rcp_f32 v100, v100
  v_cvt_pk_bf16_f32 v113, v98, v99
  v_rcp_f32 v101, v101
  v_rcp_f32 v102, v102
  v_rcp_f32 v103, v103
  v_cvt_pk_bf16_f32 v114, v100, v101
  v_cvt_pk_bf16_f32 v115, v102, v103
  s_cmp_eq_u32 s61, 3
  ds_read_b64_tr_b16 v[120:121], v9 offset:0
  v_mfma_f32_16x16x32_bf16 v[116:119], v[112:115], v[80:83], v[84:87]
  ds_read_b64_tr_b16 v[122:123], v9 offset:32
  s_cbranch_scc1 L_flushDUn
  s_waitcnt vmcnt(4)
  v_mfma_f32_16x16x32_bf16 v[104:107], v[64:67], v[44:47], v[72:75]
  ds_write_b128 v8, v[44:47] offset:1280
  v_mfma_f32_16x16x32_bf16 v[108:111], v[68:71], v[44:47], v[76:79]
  s_waitcnt lgkmcnt(1)
  s_nop 0
  v_cvt_pk_bf16_f32 v28, v116, v117
  v_cvt_pk_bf16_f32 v29, v118, v119
  s_nop 1
  v_mfma_f32_16x16x16_bf16 v[88:91], v[28:29], v[120:121], v[88:91]
  v_exp_f32 v104, v104
  v_exp_f32 v105, v105
  v_mfma_f32_16x16x16_bf16 v[92:95], v[28:29], v[122:123], v[92:95]
  v_exp_f32 v106, v106
  v_exp_f32 v107, v107
  v_exp_f32 v108, v108
  v_exp_f32 v109, v109
  v_exp_f32 v110, v110
  v_exp_f32 v111, v111
  v_pk_add_f32 v[104:105], v[104:105], 1.0 op_sel_hi:[1,0]
  v_pk_add_f32 v[106:107], v[106:107], 1.0 op_sel_hi:[1,0]
  v_pk_add_f32 v[108:109], v[108:109], 1.0 op_sel_hi:[1,0]
  v_pk_add_f32 v[110:111], v[110:111], 1.0 op_sel_hi:[1,0]
  v_rcp_f32 v104, v104
  v_rcp_f32 v105, v105
  v_rcp_f32 v106, v106
  v_cvt_pk_bf16_f32 v112, v104, v105
  v_rcp_f32 v107, v107
  v_rcp_f32 v108, v108
  v_cvt_pk_bf16_f32 v113, v106, v107
  v_rcp_f32 v109, v109
  v_rcp_f32 v110, v110
  v_rcp_f32 v111, v111
  v_cvt_pk_bf16_f32 v114, v108, v109
  v_cvt_pk_bf16_f32 v115, v110, v111
  s_cmp_eq_u32 s61, 4
  ds_read_b64_tr_b16 v[120:121], v9 offset:1280
  v_mfma_f32_16x16x32_bf16 v[116:119], v[112:115], v[80:83], v[84:87]
  ds_read_b64_tr_b16 v[122:123], v9 offset:1312
  s_cbranch_scc1 L_flushDUn
  s_waitcnt vmcnt(3)
  v_mfma_f32_16x16x32_bf16 v[96:99], v[64:67], v[48:51], v[72:75]
  ds_write_b128 v8, v[48:51] offset:0
  v_mfma_f32_16x16x32_bf16 v[100:103], v[68:71], v[48:51], v[76:79]
  s_waitcnt lgkmcnt(1)
  s_nop 0
  v_cvt_pk_bf16_f32 v28, v116, v117
  v_cvt_pk_bf16_f32 v29, v118, v119
  s_nop 1
  v_mfma_f32_16x16x16_bf16 v[88:91], v[28:29], v[120:121], v[88:91]
  v_exp_f32 v96, v96
  v_exp_f32 v97, v97
  v_mfma_f32_16x16x16_bf16 v[92:95], v[28:29], v[122:123], v[92:95]
  v_exp_f32 v98, v98
  v_exp_f32 v99, v99
  v_exp_f32 v100, v100
  v_exp_f32 v101, v101
  v_exp_f32 v102, v102
  v_exp_f32 v103, v103
  v_pk_add_f32 v[96:97], v[96:97], 1.0 op_sel_hi:[1,0]
  v_pk_add_f32 v[98:99], v[98:99], 1.0 op_sel_hi:[1,0]
  v_pk_add_f32 v[100:101], v[100:101], 1.0 op_sel_hi:[1,0]
  v_pk_add_f32 v[102:103], v[102:103], 1.0 op_sel_hi:[1,0]
  v_rcp_f32 v96, v96
  v_rcp_f32 v97, v97
  v_rcp_f32 v98, v98
  v_cvt_pk_bf16_f32 v112, v96, v97
  v_rcp_f32 v99, v99
  v_rcp_f32 v100, v100
  v_cvt_pk_bf16_f32 v113, v98, v99
  v_rcp_f32 v101, v101
  v_rcp_f32 v102, v102
  v_rcp_f32 v103, v103
  v_cvt_pk_bf16_f32 v114, v100, v101
  v_cvt_pk_bf16_f32 v115, v102, v103
  s_cmp_eq_u32 s61, 5
  ds_read_b64_tr_b16 v[120:121], v9 offset:0
  v_mfma_f32_16x16x32_bf16 v[116:119], v[112:115], v[80:83], v[84:87]
  ds_read_b64_tr_b16 v[122:123], v9 offset:32
  s_cbranch_scc1 L_flushDUn
  s_waitcnt vmcnt(2)
  v_mfma_f32_16x16x32_bf16 v[104:107], v[64:67], v[52:55], v[72:75]
  ds_write_b128 v8, v[52:55] offset:1280
  v_mfma_f32_16x16x32_bf16 v[108:111], v[68:71], v[52:55], v[76:79]
  s_waitcnt lgkmcnt(1)
  s_nop 0
  v_cvt_pk_bf16_f32 v28, v116, v117
  v_cvt_pk_bf16_f32 v29, v118, v119
  s_nop 1
  v_mfma_f32_16x16x16_bf16 v[88:91], v[28:29], v[120:121], v[88:91]
  v_exp_f32 v104, v104
  v_exp_f32 v105, v105
  v_mfma_f32_16x16x16_bf16 v[92:95], v[28:29], v[122:123], v[92:95]
  v_exp_f32 v106, v106
  v_exp_f32 v107, v107
  v_exp_f32 v108, v108
  v_exp_f32 v109, v109
  v_exp_f32 v110, v110
  v_exp_f32 v111, v111
  v_pk_add_f32 v[104:105], v[104:105], 1.0 op_sel_hi:[1,0]
  v_pk_add_f32 v[106:107], v[106:107], 1.0 op_sel_hi:[1,0]
  v_pk_add_f32 v[108:109], v[108:109], 1.0 op_sel_hi:[1,0]
  v_pk_add_f32 v[110:111], v[110:111], 1.0 op_sel_hi:[1,0]
  v_rcp_f32 v104, v104
  v_rcp_f32 v105, v105
  v_rcp_f32 v106, v106
  v_cvt_pk_bf16_f32 v112, v104, v105
  v_rcp_f32 v107, v107
  v_rcp_f32 v108, v108
  v_cvt_pk_bf16_f32 v113, v106, v107
  v_rcp_f32 v109, v109
  v_rcp_f32 v110, v110
  v_rcp_f32 v111, v111
  v_cvt_pk_bf16_f32 v114, v108, v109
  v_cvt_pk_bf16_f32 v115, v110, v111
  s_cmp_eq_u32 s61, 6
  ds_read_b64_tr_b16 v[120:121], v9 offset:1280
  v_mfma_f32_16x16x32_bf16 v[116:119], v[112:115], v[80:83], v[84:87]
  ds_read_b64_tr_b16 v[122:123], v9 offset:1312
  s_cbranch_scc1 L_flushDUn
  s_waitcnt vmcnt(1)
  v_mfma_f32_16x16x32_bf16 v[96:99], v[64:67], v[56:59], v[72:75]
  ds_write_b128 v8, v[56:59] offset:0
  v_mfma_f32_16x16x32_bf16 v[100:103], v[68:71], v[56:59], v[76:79]
  s_waitcnt lgkmcnt(1)
  s_nop 0
  v_cvt_pk_bf16_f32 v28, v116, v117
  v_cvt_pk_bf16_f32 v29, v118, v119
  s_nop 1
  v_mfma_f32_16x16x16_bf16 v[88:91], v[28:29], v[120:121], v[88:91]
  v_exp_f32 v96, v96
  v_exp_f32 v97, v97
  v_mfma_f32_16x16x16_bf16 v[92:95], v[28:29], v[122:123], v[92:95]
  v_exp_f32 v98, v98
  v_exp_f32 v99, v99
  v_exp_f32 v100, v100
  v_exp_f32 v101, v101
  v_exp_f32 v102, v102
  v_exp_f32 v103, v103
  v_pk_add_f32 v[96:97], v[96:97], 1.0 op_sel_hi:[1,0]
  v_pk_add_f32 v[98:99], v[98:99], 1.0 op_sel_hi:[1,0]
  v_pk_add_f32 v[100:101], v[100:101], 1.0 op_sel_hi:[1,0]
  v_pk_add_f32 v[102:103], v[102:103], 1.0 op_sel_hi:[1,0]
  v_rcp_f32 v96, v96
  v_rcp_f32 v97, v97
  v_rcp_f32 v98, v98
  v_cvt_pk_bf16_f32 v112, v96, v97
  v_rcp_f32 v99, v99
  v_rcp_f32 v100, v100
  v_cvt_pk_bf16_f32 v113, v98, v99
  v_rcp_f32 v101, v101
  v_rcp_f32 v102, v102
  v_rcp_f32 v103, v103
  v_cvt_pk_bf16_f32 v114, v100, v101
  v_cvt_pk_bf16_f32 v115, v102, v103
  s_cmp_eq_u32 s61, 7
  ds_read_b64_tr_b16 v[120:121], v9 offset:0
  v_mfma_f32_16x16x32_bf16 v[116:119], v[112:115], v[80:83], v[84:87]
  ds_read_b64_tr_b16 v[122:123], v9 offset:32
  s_cbranch_scc1 L_flushDUn
  s_waitcnt vmcnt(0)
  v_mfma_f32_16x16x32_bf16 v[104:107], v[64:67], v[60:63], v[72:75]
  ds_write_b128 v8, v[60:63] offset:1280
  v_mfma_f32_16x16x32_bf16 v[108:111], v[68:71], v[60:63], v[76:79]
  s_waitcnt lgkmcnt(1)
  s_nop 0
  v_cvt_pk_bf16_f32 v28, v116, v117
  v_cvt_pk_bf16_f32 v29, v118, v119
  s_nop 1
  v_mfma_f32_16x16x16_bf16 v[88:91], v[28:29], v[120:121], v[88:91]
  v_exp_f32 v104, v104
  v_exp_f32 v105, v105
  v_mfma_f32_16x16x16_bf16 v[92:95], v[28:29], v[122:123], v[92:95]
  v_exp_f32 v106, v106
  v_exp_f32 v107, v107
  v_exp_f32 v108, v108
  v_exp_f32 v109, v109
  v_exp_f32 v110, v110
  v_exp_f32 v111, v111
  v_pk_add_f32 v[104:105], v[104:105], 1.0 op_sel_hi:[1,0]
  v_pk_add_f32 v[106:107], v[106:107], 1.0 op_sel_hi:[1,0]
  v_pk_add_f32 v[108:109], v[108:109], 1.0 op_sel_hi:[1,0]
  v_pk_add_f32 v[110:111], v[110:111], 1.0 op_sel_hi:[1,0]
  v_rcp_f32 v104, v104
  v_rcp_f32 v105, v105
  v_rcp_f32 v106, v106
  v_cvt_pk_bf16_f32 v112, v104, v105
  v_rcp_f32 v107, v107
  v_rcp_f32 v108, v108
  v_cvt_pk_bf16_f32 v113, v106, v107
  v_rcp_f32 v109, v109
  v_rcp_f32 v110, v110
  v_rcp_f32 v111, v111
  v_cvt_pk_bf16_f32 v114, v108, v109
  v_cvt_pk_bf16_f32 v115, v110, v111
  s_cmp_eq_u32 s61, 8
  ds_read_b64_tr_b16 v[120:121], v9 offset:1280
  v_mfma_f32_16x16x32_bf16 v[116:119], v[112:115], v[80:83], v[84:87]
  ds_read_b64_tr_b16 v[122:123], v9 offset:1312
  s_cbranch_scc1 L_flushDUn
  s_nop 4
  s_waitcnt lgkmcnt(0)
  v_cvt_pk_bf16_f32 v28, v116, v117
  v_cvt_pk_bf16_f32 v29, v118, v119
  s_nop 1
  v_mfma_f32_16x16x16_bf16 v[88:91], v[28:29], v[120:121], v[88:91]
  v_mfma_f32_16x16x16_bf16 v[92:95], v[28:29], v[122:123], v[92:95]
  s_nop 7
  s_mov_b32 s68, 1
  s_sub_u32 s61, s61, 8
  v_mov_b32 v12, v88
  v_mov_b32 v124, v92
  v_mov_b32 v13, v89
  v_mov_b32 v125, v93
  v_mov_b32 v14, v90
  v_mov_b32 v126, v94
  v_mov_b32 v15, v91
  v_mov_b32 v127, v95
  v_add_u32 v6, 1024, v6
  v_add_u32 v7, 1024, v7
  s_waitcnt vmcnt(0)
  ds_read_b32 v16, v6 offset:0
  ds_read_b32 v17, v6 offset:128
  ds_read_b32 v18, v6 offset:256
  ds_read_b32 v19, v6 offset:384
  ds_read_b32 v20, v6 offset:512
  ds_read_b32 v21, v6 offset:640
  ds_read_b32 v22, v6 offset:768
  ds_read_b32 v23, v6 offset:896
  s_waitcnt lgkmcnt(0)
  v_add_u32 v16, v16, v5
  buffer_load_dwordx4 v[32:35], v16, s[20:23], 0 offen nt
  v_add_u32 v17, v17, v5
  buffer_load_dwordx4 v[36:39], v17, s[20:23], 0 offen nt
  v_add_u32 v18, v18, v5
  buffer_load_dwordx4 v[40:43], v18, s[20:23], 0 offen nt
  v_add_u32 v19, v19, v5
  buffer_load_dwordx4 v[44:47], v19, s[20:23], 0 offen nt
  v_add_u32 v20, v20, v5
  buffer_load_dwordx4 v[48:51], v20, s[20:23], 0 offen nt
  v_add_u32 v21, v21, v5
  buffer_load_dwordx4 v[52:55], v21, s[20:23], 0 offen nt
  v_add_u32 v22, v22, v5
  buffer_load_dwordx4 v[56:59], v22, s[20:23], 0 offen nt
  v_add_u32 v23, v23, v5
  buffer_load_dwordx4 v[60:63], v23, s[20:23], 0 offen nt
  s_branch L_roundU8
L_flushDUn:
  v_lshlrev_b32 v1, 1, v2
  s_cmp_eq_u32 s68, 0
  s_nop 2
  s_waitcnt lgkmcnt(0)
  v_cvt_pk_bf16_f32 v28, v116, v117
  v_cvt_pk_bf16_f32 v29, v118, v119
  s_nop 1
  v_mfma_f32_16x16x16_bf16 v[88:91], v[28:29], v[120:121], v[88:91]
  v_mfma_f32_16x16x16_bf16 v[92:95], v[28:29], v[122:123], v[92:95]
  s_cbranch_scc0 L_finR2
  s_nop 5
  s_mov_b64 exec, 0xffff
  v_cvt_pk_bf16_f32 v112, v88, v92
  buffer_store_short v112, v1, s[36:39], 0 offen
  buffer_store_short_d16_hi v112, v1, s[36:39], 0 offen offset:32
  s_endpgm
L_flushDU0:
  v_lshlrev_b32 v1, 1, v2
  s_cmp_eq_u32 s68, 0
  s_nop 2
  s_waitcnt lgkmcnt(0)
  v_pk_mul_f32 v[116:117], v[116:117], v[24:25]
  v_pk_mul_f32 v[118:119], v[118:119], v[26:27]
  v_cvt_pk_bf16_f32 v28, v116, v117
  v_cvt_pk_bf16_f32 v29, v118, v119
  s_nop 1
  v_mfma_f32_16x16x16_bf16 v[88:91], v[28:29], v[120:121], 0
  v_mfma_f32_16x16x16_bf16 v[92:95], v[28:29], v[122:123], 0
  s_cbranch_scc0 L_finR2
  s_nop 5
  s_mov_b64 exec, 0xffff
  v_cvt_pk_bf16_f32 v112, v88, v92
  buffer_store_short v112, v1, s[36:39], 0 offen
  buffer_store_short_d16_hi v112, v1, s[36:39], 0 offen offset:32
  s_endpgm
L_finR2:
  s_branch L_fin
L_zero:
  v_mov_b32 v88, 0
  v_mov_b32 v92, 0
  s_branch L_fin2
L_fin:
  s_cmp_eq_u32 s68, 0
  s_nop 6
  s_cbranch_scc1 L_fin2
  v_add_f32 v88, v88, v12
  v_add_f32 v92, v92, v124
L_fin2:
  v_cvt_pk_bf16_f32 v112, v88, v92
  v_lshlrev_b32 v1, 1, v2
  s_mov_b64 exec, 0xffff
  buffer_store_short v112, v1, s[36:39], 0 offen
  buffer_store_short_d16_hi v112, v1, s[36:39], 0 offen offset:32
L_end:
  s_endpgm
L_round8:
  s_waitcnt vmcnt(7)
  v_mfma_f32_16x16x32_bf16 v[96:99], v[64:67], v[32:35], v[72:75]
  ds_write_b128 v8, v[32:35] offset:0
  v_mfma_f32_16x16x32_bf16 v[100:103], v[68:71], v[32:35], v[76:79]
  s_nop 5
  v_exp_f32 v96, v96
  ds_read2_b32 v[24:25], v7 offset0:1 offset1:3
  v_exp_f32 v97, v97
  ds_read2_b32 v[26:27], v7 offset0:5 offset1:7
  v_exp_f32 v98, v98
  v_exp_f32 v99, v99
  v_exp_f32 v100, v100
  v_exp_f32 v101, v101
  v_exp_f32 v102, v102
  v_exp_f32 v103, v103
  v_pk_add_f32 v[96:97], v[96:97], 1.0 op_sel_hi:[1,0]
  v_pk_add_f32 v[98:99], v[98:99], 1.0 op_sel_hi:[1,0]
  v_pk_add_f32 v[100:101], v[100:101], 1.0 op_sel_hi:[1,0]
  v_pk_add_f32 v[102:103], v[102:103], 1.0 op_sel_hi:[1,0]
  v_rcp_f32 v96, v96
  v_rcp_f32 v97, v97
  v_rcp_f32 v98, v98
  v_cvt_pk_bf16_f32 v112, v96, v97
  v_rcp_f32 v99, v99
  v_rcp_f32 v100, v100
  v_cvt_pk_bf16_f32 v113, v98, v99
  v_rcp_f32 v101, v101
  v_rcp_f32 v102, v102
  v_rcp_f32 v103, v103
  v_cvt_pk_bf16_f32 v114, v100, v101
  v_cvt_pk_bf16_f32 v115, v102, v103
  s_cmp_eq_u32 s61, 1
  ds_read_b64_tr_b16 v[120:121], v9 offset:0
  v_mfma_f32_16x16x32_bf16 v[116:119], v[112:115], v[80:83], v[84:87]
  ds_read_b64_tr_b16 v[122:123], v9 offset:32
  s_cbranch_scc1 L_flushD0
  s_waitcnt vmcnt(6)
  v_mfma_f32_16x16x32_bf16 v[104:107], v[64:67], v[36:39], v[72:75]
  ds_write_b128 v8, v[36:39] offset:1280
  v_mfma_f32_16x16x32_bf16 v[108:111], v[68:71], v[36:39], v[76:79]
  s_waitcnt lgkmcnt(1)
  s_nop 0
  v_pk_mul_f32 v[116:117], v[116:117], v[24:25]
  v_pk_mul_f32 v[118:119], v[118:119], v[26:27]
  v_cvt_pk_bf16_f32 v28, v116, v117
  v_cvt_pk_bf16_f32 v29, v118, v119
  v_exp_f32 v104, v104
  ds_read2_b32 v[24:25], v7 offset0:33 offset1:35
  v_mfma_f32_16x16x16_bf16 v[88:91], v[28:29], v[120:121], 0
  v_exp_f32 v105, v105
  ds_read2_b32 v[26:27], v7 offset0:37 offset1:39
  v_mfma_f32_16x16x16_bf16 v[92:95], v[28:29], v[122:123], 0
  v_exp_f32 v106, v106
  v_exp_f32 v107, v107
  v_exp_f32 v108, v108
  v_exp_f32 v109, v109
  v_exp_f32 v110, v110
  v_exp_f32 v111, v111
  v_pk_add_f32 v[104:105], v[104:105], 1.0 op_sel_hi:[1,0]
  v_pk_add_f32 v[106:107], v[106:107], 1.0 op_sel_hi:[1,0]
  v_pk_add_f32 v[108:109], v[108:109], 1.0 op_sel_hi:[1,0]
  v_pk_add_f32 v[110:111], v[110:111], 1.0 op_sel_hi:[1,0]
  v_rcp_f32 v104, v104
  v_rcp_f32 v105, v105
  v_rcp_f32 v106, v106
  v_cvt_pk_bf16_f32 v112, v104, v105
  v_rcp_f32 v107, v107
  v_rcp_f32 v108, v108
  v_cvt_pk_bf16_f32 v113, v106, v107
  v_rcp_f32 v109, v109
  v_rcp_f32 v110, v110
  v_rcp_f32 v111, v111
  v_cvt_pk_bf16_f32 v114, v108, v109
  v_cvt_pk_bf16_f32 v115, v110, v111
  s_cmp_eq_u32 s61, 2
  ds_read_b64_tr_b16 v[120:121], v9 offset:1280
  v_mfma_f32_16x16x32_bf16 v[116:119], v[112:115], v[80:83], v[84:87]
  ds_read_b64_tr_b16 v[122:123], v9 offset:1312
  s_cbranch_scc1 L_flushDn
  s_waitcnt vmcnt(5)
  v_mfma_f32_16x16x32_bf16 v[96:99], v[64:67], v[40:43], v[72:75]
  ds_write_b128 v8, v[40:43] offset:0
  v_mfma_f32_16x16x32_bf16 v[100:103], v[68:71], v[40:43], v[76:79]
  s_waitcnt lgkmcnt(1)
  s_nop 0
  v_pk_mul_f32 v[116:117], v[116:117], v[24:25]
  v_pk_mul_f32 v[118:119], v[118:119], v[26:27]
  v_cvt_pk_bf16_f32 v28, v116, v117
  v_cvt_pk_bf16_f32 v29, v118, v119
  v_exp_f32 v96, v96
  ds_read2_b32 v[24:25], v7 offset0:65 offset1:67
  v_mfma_f32_16x16x16_bf16 v[88:91], v[28:29], v[120:121], v[88:91]
  v_exp_f32 v97, v97
  ds_read2_b32 v[26:27], v7 offset0:69 offset1:71
  v_mfma_f32_16x16x16_bf16 v[92:95], v[28:29], v[122:123], v[92:95]
  v_exp_f32 v98, v98
  v_exp_f32 v99, v99
  v_exp_f32 v100, v100
  v_exp_f32 v101, v101
  v_exp_f32 v102, v102
  v_exp_f32 v103, v103
  v_pk_add_f32 v[96:97], v[96:97], 1.0 op_sel_hi:[1,0]
  v_pk_add_f32 v[98:99], v[98:99], 1.0 op_sel_hi:[1,0]
  v_pk_add_f32 v[100:101], v[100:101], 1.0 op_sel_hi:[1,0]
  v_pk_add_f32 v[102:103], v[102:103], 1.0 op_sel_hi:[1,0]
  v_rcp_f32 v96, v96
  v_rcp_f32 v97, v97
  v_rcp_f32 v98, v98
  v_cvt_pk_bf16_f32 v112, v96, v97
  v_rcp_f32 v99, v99
  v_rcp_f32 v100, v100
  v_cvt_pk_bf16_f32 v113, v98, v99
  v_rcp_f32 v101, v101
  v_rcp_f32 v102, v102
  v_rcp_f32 v103, v103
  v_cvt_pk_bf16_f32 v114, v100, v101
  v_cvt_pk_bf16_f32 v115, v102, v103
  s_cmp_eq_u32 s61, 3
  ds_read_b64_tr_b16 v[120:121], v9 offset:0
  v_mfma_f32_16x16x32_bf16 v[116:119], v[112:115], v[80:83], v[84:87]
  ds_read_b64_tr_b16 v[122:123], v9 offset:32
  s_cbranch_scc1 L_flushDn
  s_waitcnt vmcnt(4)
  v_mfma_f32_16x16x32_bf16 v[104:107], v[64:67], v[44:47], v[72:75]
  ds_write_b128 v8, v[44:47] offset:1280
  v_mfma_f32_16x16x32_bf16 v[108:111], v[68:71], v[44:47], v[76:79]
  s_waitcnt lgkmcnt(1)
  s_nop 0
  v_pk_mul_f32 v[116:117], v[116:117], v[24:25]
  v_pk_mul_f32 v[118:119], v[118:119], v[26:27]
  v_cvt_pk_bf16_f32 v28, v116, v117
  v_cvt_pk_bf16_f32 v29, v118, v119
  v_exp_f32 v104, v104
  ds_read2_b32 v[24:25], v7 offset0:97 offset1:99
  v_mfma_f32_16x16x16_bf16 v[88:91], v[28:29], v[120:121], v[88:91]
  v_exp_f32 v105, v105
  ds_read2_b32 v[26:27], v7 offset0:101 offset1:103
  v_mfma_f32_16x16x16_bf16 v[92:95], v[28:29], v[122:123], v[92:95]
  v_exp_f32 v106, v106
  v_exp_f32 v107, v107
  v_exp_f32 v108, v108
  v_exp_f32 v109, v109
  v_exp_f32 v110, v110
  v_exp_f32 v111, v111
  v_pk_add_f32 v[104:105], v[104:105], 1.0 op_sel_hi:[1,0]
  v_pk_add_f32 v[106:107], v[106:107], 1.0 op_sel_hi:[1,0]
  v_pk_add_f32 v[108:109], v[108:109], 1.0 op_sel_hi:[1,0]
  v_pk_add_f32 v[110:111], v[110:111], 1.0 op_sel_hi:[1,0]
  v_rcp_f32 v104, v104
  v_rcp_f32 v105, v105
  v_rcp_f32 v106, v106
  v_cvt_pk_bf16_f32 v112, v104, v105
  v_rcp_f32 v107, v107
  v_rcp_f32 v108, v108
  v_cvt_pk_bf16_f32 v113, v106, v107
  v_rcp_f32 v109, v109
  v_rcp_f32 v110, v110
  v_rcp_f32 v111, v111
  v_cvt_pk_bf16_f32 v114, v108, v109
  v_cvt_pk_bf16_f32 v115, v110, v111
  s_cmp_eq_u32 s61, 4
  ds_read_b64_tr_b16 v[120:121], v9 offset:1280
  v_mfma_f32_16x16x32_bf16 v[116:119], v[112:115], v[80:83], v[84:87]
  ds_read_b64_tr_b16 v[122:123], v9 offset:1312
  s_cbranch_scc1 L_flushDn
  s_waitcnt vmcnt(3)
  v_mfma_f32_16x16x32_bf16 v[96:99], v[64:67], v[48:51], v[72:75]
  ds_write_b128 v8, v[48:51] offset:0
  v_mfma_f32_16x16x32_bf16 v[100:103], v[68:71], v[48:51], v[76:79]
  s_waitcnt lgkmcnt(1)
  s_nop 0
  v_pk_mul_f32 v[116:117], v[116:117], v[24:25]
  v_pk_mul_f32 v[118:119], v[118:119], v[26:27]
  v_cvt_pk_bf16_f32 v28, v116, v117
  v_cvt_pk_bf16_f32 v29, v118, v119
  v_exp_f32 v96, v96
  ds_read2_b32 v[24:25], v7 offset0:129 offset1:131
  v_mfma_f32_16x16x16_bf16 v[88:91], v[28:29], v[120:121], v[88:91]
  v_exp_f32 v97, v97
  ds_read2_b32 v[26:27], v7 offset0:133 offset1:135
  v_mfma_f32_16x16x16_bf16 v[92:95], v[28:29], v[122:123], v[92:95]
  v_exp_f32 v98, v98
  v_exp_f32 v99, v99
  v_exp_f32 v100, v100
  v_exp_f32 v101, v101
  v_exp_f32 v102, v102
  v_exp_f32 v103, v103
  v_pk_add_f32 v[96:97], v[96:97], 1.0 op_sel_hi:[1,0]
  v_pk_add_f32 v[98:99], v[98:99], 1.0 op_sel_hi:[1,0]
  v_pk_add_f32 v[100:101], v[100:101], 1.0 op_sel_hi:[1,0]
  v_pk_add_f32 v[102:103], v[102:103], 1.0 op_sel_hi:[1,0]
  v_rcp_f32 v96, v96
  v_rcp_f32 v97, v97
  v_rcp_f32 v98, v98
  v_cvt_pk_bf16_f32 v112, v96, v97
  v_rcp_f32 v99, v99
  v_rcp_f32 v100, v100
  v_cvt_pk_bf16_f32 v113, v98, v99
  v_rcp_f32 v101, v101
  v_rcp_f32 v102, v102
  v_rcp_f32 v103, v103
  v_cvt_pk_bf16_f32 v114, v100, v101
  v_cvt_pk_bf16_f32 v115, v102, v103
  s_cmp_eq_u32 s61, 5
  ds_read_b64_tr_b16 v[120:121], v9 offset:0
  v_mfma_f32_16x16x32_bf16 v[116:119], v[112:115], v[80:83], v[84:87]
  ds_read_b64_tr_b16 v[122:123], v9 offset:32
  s_cbranch_scc1 L_flushDn
  s_waitcnt vmcnt(2)
  v_mfma_f32_16x16x32_bf16 v[104:107], v[64:67], v[52:55], v[72:75]
  ds_write_b128 v8, v[52:55] offset:1280
  v_mfma_f32_16x16x32_bf16 v[108:111], v[68:71], v[52:55], v[76:79]
  s_waitcnt lgkmcnt(1)
  s_nop 0
  v_pk_mul_f32 v[116:117], v[116:117], v[24:25]
  v_pk_mul_f32 v[118:119], v[118:119], v[26:27]
  v_cvt_pk_bf16_f32 v28, v116, v117
  v_cvt_pk_bf16_f32 v29, v118, v119
  v_exp_f32 v104, v104
  ds_read2_b32 v[24:25], v7 offset0:161 offset1:163
  v_mfma_f32_16x16x16_bf16 v[88:91], v[28:29], v[120:121], v[88:91]
  v_exp_f32 v105, v105
  ds_read2_b32 v[26:27], v7 offset0:165 offset1:167
  v_mfma_f32_16x16x16_bf16 v[92:95], v[28:29], v[122:123], v[92:95]
  v_exp_f32 v106, v106
  v_exp_f32 v107, v107
  v_exp_f32 v108, v108
  v_exp_f32 v109, v109
  v_exp_f32 v110, v110
  v_exp_f32 v111, v111
  v_pk_add_f32 v[104:105], v[104:105], 1.0 op_sel_hi:[1,0]
  v_pk_add_f32 v[106:107], v[106:107], 1.0 op_sel_hi:[1,0]
  v_pk_add_f32 v[108:109], v[108:109], 1.0 op_sel_hi:[1,0]
  v_pk_add_f32 v[110:111], v[110:111], 1.0 op_sel_hi:[1,0]
  v_rcp_f32 v104, v104
  v_rcp_f32 v105, v105
  v_rcp_f32 v106, v106
  v_cvt_pk_bf16_f32 v112, v104, v105
  v_rcp_f32 v107, v107
  v_rcp_f32 v108, v108
  v_cvt_pk_bf16_f32 v113, v106, v107
  v_rcp_f32 v109, v109
  v_rcp_f32 v110, v110
  v_rcp_f32 v111, v111
  v_cvt_pk_bf16_f32 v114, v108, v109
  v_cvt_pk_bf16_f32 v115, v110, v111
  s_cmp_eq_u32 s61, 6
  ds_read_b64_tr_b16 v[120:121], v9 offset:1280
  v_mfma_f32_16x16x32_bf16 v[116:119], v[112:115], v[80:83], v[84:87]
  ds_read_b64_tr_b16 v[122:123], v9 offset:1312
  s_cbranch_scc1 L_flushDn
  s_waitcnt vmcnt(1)
  v_mfma_f32_16x16x32_bf16 v[96:99], v[64:67], v[56:59], v[72:75]
  ds_write_b128 v8, v[56:59] offset:0
  v_mfma_f32_16x16x32_bf16 v[100:103], v[68:71], v[56:59], v[76:79]
  s_waitcnt lgkmcnt(1)
  s_nop 0
  v_pk_mul_f32 v[116:117], v[116:117], v[24:25]
  v_pk_mul_f32 v[118:119], v[118:119], v[26:27]
  v_cvt_pk_bf16_f32 v28, v116, v117
  v_cvt_pk_bf16_f32 v29, v118, v119
  v_exp_f32 v96, v96
  ds_read2_b32 v[24:25], v7 offset0:193 offset1:195
  v_mfma_f32_16x16x16_bf16 v[88:91], v[28:29], v[120:121], v[88:91]
  v_exp_f32 v97, v97
  ds_read2_b32 v[26:27], v7 offset0:197 offset1:199
  v_mfma_f32_16x16x16_bf16 v[92:95], v[28:29], v[122:123], v[92:95]
  v_exp_f32 v98, v98
  v_exp_f32 v99, v99
  v_exp_f32 v100, v100
  v_exp_f32 v101, v101
  v_exp_f32 v102, v102
  v_exp_f32 v103, v103
  v_pk_add_f32 v[96:97], v[96:97], 1.0 op_sel_hi:[1,0]
  v_pk_add_f32 v[98:99], v[98:99], 1.0 op_sel_hi:[1,0]
  v_pk_add_f32 v[100:101], v[100:101], 1.0 op_sel_hi:[1,0]
  v_pk_add_f32 v[102:103], v[102:103], 1.0 op_sel_hi:[1,0]
  v_rcp_f32 v96, v96
  v_rcp_f32 v97, v97
  v_rcp_f32 v98, v98
  v_cvt_pk_bf16_f32 v112, v96, v97
  v_rcp_f32 v99, v99
  v_rcp_f32 v100, v100
  v_cvt_pk_bf16_f32 v113, v98, v99
  v_rcp_f32 v101, v101
  v_rcp_f32 v102, v102
  v_rcp_f32 v103, v103
  v_cvt_pk_bf16_f32 v114, v100, v101
  v_cvt_pk_bf16_f32 v115, v102, v103
  s_cmp_eq_u32 s61, 7
  ds_read_b64_tr_b16 v[120:121], v9 offset:0
  v_mfma_f32_16x16x32_bf16 v[116:119], v[112:115], v[80:83], v[84:87]
  ds_read_b64_tr_b16 v[122:123], v9 offset:32
  s_cbranch_scc1 L_flushDn
  s_waitcnt vmcnt(0)
  v_mfma_f32_16x16x32_bf16 v[104:107], v[64:67], v[60:63], v[72:75]
  ds_write_b128 v8, v[60:63] offset:1280
  v_mfma_f32_16x16x32_bf16 v[108:111], v[68:71], v[60:63], v[76:79]
  s_waitcnt lgkmcnt(1)
  s_nop 0
  v_pk_mul_f32 v[116:117], v[116:117], v[24:25]
  v_pk_mul_f32 v[118:119], v[118:119], v[26:27]
  v_cvt_pk_bf16_f32 v28, v116, v117
  v_cvt_pk_bf16_f32 v29, v118, v119
  v_exp_f32 v104, v104
  ds_read2_b32 v[24:25], v7 offset0:225 offset1:227
  v_mfma_f32_16x16x16_bf16 v[88:91], v[28:29], v[120:121], v[88:91]
  v_exp_f32 v105, v105
  ds_read2_b32 v[26:27], v7 offset0:229 offset1:231
  v_mfma_f32_16x16x16_bf16 v[92:95], v[28:29], v[122:123], v[92:95]
  v_exp_f32 v106, v106
  v_exp_f32 v107, v107
  v_exp_f32 v108, v108
  v_exp_f32 v109, v109
  v_exp_f32 v110, v110
  v_exp_f32 v111, v111
  v_pk_add_f32 v[104:105], v[104:105], 1.0 op_sel_hi:[1,0]
  v_pk_add_f32 v[106:107], v[106:107], 1.0 op_sel_hi:[1,0]
  v_pk_add_f32 v[108:109], v[108:109], 1.0 op_sel_hi:[1,0]
  v_pk_add_f32 v[110:111], v[110:111], 1.0 op_sel_hi:[1,0]
  v_rcp_f32 v104, v104
  v_rcp_f32 v105, v105
  v_rcp_f32 v106, v106
  v_cvt_pk_bf16_f32 v112, v104, v105
  v_rcp_f32 v107, v107
  v_rcp_f32 v108, v108
  v_cvt_pk_bf16_f32 v113, v106, v107
  v_rcp_f32 v109, v109
  v_rcp_f32 v110, v110
  v_rcp_f32 v111, v111
  v_cvt_pk_bf16_f32 v114, v108, v109
  v_cvt_pk_bf16_f32 v115, v110, v111
  s_cmp_eq_u32 s61, 8
  ds_read_b64_tr_b16 v[120:121], v9 offset:1280
  v_mfma_f32_16x16x32_bf16 v[116:119], v[112:115], v[80:83], v[84:87]
  ds_read_b64_tr_b16 v[122:123], v9 offset:1312
  s_cbranch_scc1 L_flushDn
  s_nop 4
  s_waitcnt lgkmcnt(0)
  v_pk_mul_f32 v[116:117], v[116:117], v[24:25]
  v_pk_mul_f32 v[118:119], v[118:119], v[26:27]
  v_cvt_pk_bf16_f32 v28, v116, v117
  v_cvt_pk_bf16_f32 v29, v118, v119
  s_nop 1
  v_mfma_f32_16x16x16_bf16 v[88:91], v[28:29], v[120:121], v[88:91]
  v_mfma_f32_16x16x16_bf16 v[92:95], v[28:29], v[122:123], v[92:95]
  s_nop 7
  s_mov_b32 s68, 1
  s_sub_u32 s61, s61, 8
  v_mov_b32 v12, v88
  v_mov_b32 v124, v92
  v_mov_b32 v13, v89
  v_mov_b32 v125, v93
  v_mov_b32 v14, v90
  v_mov_b32 v126, v94
  v_mov_b32 v15, v91
  v_mov_b32 v127, v95
  v_add_u32 v6, 1024, v6
  v_add_u32 v7, 1024, v7
  s_waitcnt vmcnt(0)
  ds_read_b32 v16, v6 offset:0
  ds_read_b32 v17, v6 offset:128
  ds_read_b32 v18, v6 offset:256
  ds_read_b32 v19, v6 offset:384
  ds_read_b32 v20, v6 offset:512
  ds_read_b32 v21, v6 offset:640
  ds_read_b32 v22, v6 offset:768
  ds_read_b32 v23, v6 offset:896
  s_waitcnt lgkmcnt(0)
  v_add_u32 v16, v16, v5
  buffer_load_dwordx4 v[32:35], v16, s[20:23], 0 offen nt
  v_add_u32 v17, v17, v5
  buffer_load_dwordx4 v[36:39], v17, s[20:23], 0 offen nt
  v_add_u32 v18, v18, v5
  buffer_load_dwordx4 v[40:43], v18, s[20:23], 0 offen nt
  v_add_u32 v19, v19, v5
  buffer_load_dwordx4 v[44:47], v19, s[20:23], 0 offen nt
  v_add_u32 v20, v20, v5
  buffer_load_dwordx4 v[48:51], v20, s[20:23], 0 offen nt
  v_add_u32 v21, v21, v5
  buffer_load_dwordx4 v[52:55], v21, s[20:23], 0 offen nt
  v_add_u32 v22, v22, v5
  buffer_load_dwordx4 v[56:59], v22, s[20:23], 0 offen nt
  v_add_u32 v23, v23, v5
  buffer_load_dwordx4 v[60:63], v23, s[20:23], 0 offen nt
  s_branch L_round8
L_flushDn:
  v_lshlrev_b32 v1, 1, v2
  s_cmp_eq_u32 s68, 0
  s_nop 2
  s_waitcnt lgkmcnt(0)
  v_pk_mul_f32 v[116:117], v[116:117], v[24:25]
  v_pk_mul_f32 v[118:119], v[118:119], v[26:27]
  v_cvt_pk_bf16_f32 v28, v116, v117
  v_cvt_pk_bf16_f32 v29, v118, v119
  s_nop 1
  v_mfma_f32_16x16x16_bf16 v[88:91], v[28:29], v[120:121], v[88:91]
  v_mfma_f32_16x16x16_bf16 v[92:95], v[28:29], v[122:123], v[92:95]
  s_cbranch_scc0 L_finR2
  s_nop 5
  s_mov_b64 exec, 0xffff
  v_cvt_pk_bf16_f32 v112, v88, v92
  buffer_store_short v112, v1, s[36:39], 0 offen
  buffer_store_short_d16_hi v112, v1, s[36:39], 0 offen offset:32
  s_endpgm
L_flushD0:
  v_lshlrev_b32 v1, 1, v2
  s_cmp_eq_u32 s68, 0
  s_nop 2
  s_waitcnt lgkmcnt(0)
  v_pk_mul_f32 v[116:117], v[116:117], v[24:25]
  v_pk_mul_f32 v[118:119], v[118:119], v[26:27]
  v_cvt_pk_bf16_f32 v28, v116, v117
  v_cvt_pk_bf16_f32 v29, v118, v119
  s_nop 1
  v_mfma_f32_16x16x16_bf16 v[88:91], v[28:29], v[120:121], 0
  v_mfma_f32_16x16x16_bf16 v[92:95], v[28:29], v[122:123], 0
  s_cbranch_scc0 L_finR2
  s_nop 5
  s_mov_b64 exec, 0xffff
  v_cvt_pk_bf16_f32 v112, v88, v92
  buffer_store_short v112, v1, s[36:39], 0 offen
  buffer_store_short_d16_hi v112, v1, s[36:39], 0 offen offset:32
  s_endpgm
.section .rodata,"a"
.p2align 6
.amdhsa_kernel standalone__sequential_behavior_din__recsys_kernel
  .amdhsa_next_free_vgpr 128
  .amdhsa_next_free_sgpr 92
  .amdhsa_accum_offset 128
  .amdhsa_group_segment_fixed_size 0
  .amdhsa_kernarg_size 80
  .amdhsa_user_sgpr_count 2
  .amdhsa_user_sgpr_kernarg_segment_ptr 1
  .amdhsa_system_sgpr_workgroup_id_x 1
  .amdhsa_float_denorm_mode_32 3
.end_amdhsa_kernel
```
